```python
import torch

def _softmax(x, axis=-1):
    return torch.softmax(x, dim=axis)
def _gelu(x):
    return torch.nn.functional.gelu(x, approximate="tanh")
def _silu(x):
    return torch.nn.functional.silu(x)
def _sigmoid(x):
    return torch.sigmoid(x)
def _layernorm(x, axis=-1, eps=1e-5):
    m = x.mean(dim=axis, keepdim=True)
    v = x.var(dim=axis, keepdim=True, unbiased=False)
    return (x - m) / torch.sqrt(v + eps)
def _scatter_add(tgt, idx, src, axis=0):
    return tgt.clone().index_add_(axis, idx, src)
def _segment_sum(src, seg, n):
    out = torch.zeros((n,) + src.shape[1:], dtype=src.dtype)
    return out.index_add_(0, seg, src)
def _pad(x, pw):
    flat = tuple(v for pair in reversed(pw) for v in pair)
    return torch.nn.functional.pad(x, flat)

kernel_name = 'standalone__linear_kernel_rfa__prompt'

def setup_inputs():

    _w = (lambda a: (lambda t: t.to(torch.bfloat16) if t.is_floating_point() else t)(torch.as_tensor(a)))
    B, H, Sq, Sk, D, M = 1, 32, 2048, 2048, 128, 16
    return {
        "q": _w((lambda *s: torch.randn(*s, dtype=torch.bfloat16) * 0.2)(B, H, Sq, D)),
        "k": _w((lambda *s: torch.randn(*s, dtype=torch.bfloat16) * 1.6)(B, H, Sk, D)),
        "v": _w((lambda *s: torch.randn(*s, dtype=torch.bfloat16) * 1.6)(B, H, Sk, D)),
        "omega": _w((lambda *s: torch.randn(*s, dtype=torch.bfloat16) * 1.6)(M, D)),
    }

def reference(q, k, v, omega):
    d = q.shape[-1]
    m = omega.shape[0]
    scale = float(d) ** -0.25
    qs = q * scale
    ks = k * scale
    q_proj = torch.einsum("bhsd,md->bhsm", qs, omega)
    k_proj = torch.einsum("bhsd,md->bhsm", ks, omega)
    q_sq = 0.5 * torch.einsum("bhsd,bhsd->bhs", qs, qs)[..., None]
    k_sq = 0.5 * torch.einsum("bhsd,bhsd->bhs", ks, ks)[..., None]
    inv_sqrt_m = float(m) ** -0.5
    phi_q = torch.exp(q_proj - q_sq) * inv_sqrt_m + 1e-6
    phi_k = torch.exp(k_proj - k_sq) * inv_sqrt_m + 1e-6
    kv = torch.einsum("bhsm,bhsd->bhmd", phi_k, v)
    z  = torch.einsum("bhsm->bhm", phi_k)
    num = torch.einsum("bhqm,bhmd->bhqd", phi_q, kv)
    den = torch.einsum("bhqm,bhm->bhq", phi_q, z)[..., None] + 1e-6
    return num / den
```

```asm
; @launch grid=(256,1,1) block=(1024,1,1) lds=148480
.amdgcn_target "amdgcn-amd-amdhsa--gfx950"
.text
.globl standalone__linear_kernel_rfa__prompt_kernel
.p2align 8
.type standalone__linear_kernel_rfa__prompt_kernel,@function
standalone__linear_kernel_rfa__prompt_kernel:
    s_load_dwordx2 s[28:29], s[0:1], 8
    s_load_dwordx2 s[40:41], s[0:1], 24
    s_load_dwordx2 s[32:33], s[0:1], 16
    s_load_dwordx2 s[44:45], s[0:1], 48
    s_load_dwordx2 s[24:25], s[0:1], 0
    s_load_dwordx2 s[36:37], s[0:1], 32
    s_cmp_ge_u32 s2, 256
    s_cbranch_scc1 L_end
    v_lshrrev_b32 v60, 6, v0
    v_and_b32 v1, 63, v0
    v_readfirstlane_b32 s19, v60
    s_and_b32 s3, s2, 7
    s_lshl_b32 s3, s3, 5
    s_lshr_b32 s18, s2, 3
    s_add_u32 s18, s18, s3
    v_and_b32 v2, 15, v1
    v_lshrrev_b32 v3, 4, v1
    v_xor_b32 v60, v2, v3
    v_lshlrev_b32 v60, 4, v60
    v_lshl_add_u32 v4, v3, 8, v60
    v_xor_b32 v5, 64, v4
    v_xor_b32 v6, 128, v4
    v_xor_b32 v7, 192, v4
    s_lshl_b32 s20, s19, 12
    s_lshl_b32 s21, s18, 16
    s_add_u32 s21, s21, s20
    s_mov_b32 s30, 16777216
    s_mov_b32 s31, 0x20000
    s_mov_b32 s42, 4096
    s_mov_b32 s43, 0x20000
    s_mov_b32 s34, 16777216
    s_mov_b32 s35, 0x20000
    s_mov_b32 s26, 16777216
    s_mov_b32 s27, 0x20000
    s_mov_b32 s38, 16777216
    s_mov_b32 s39, 0x20000
    s_mov_b32 s46, 268435456
    s_mov_b32 s47, 0x20000
    s_lshl_b32 s55, s18, 14
    s_and_b32 s54, s55, 0xfffe0000
    s_add_u32 s54, s54, 12288
    s_mov_b32 m0, s20
    s_cmp_lg_u32 s19, 0
    s_waitcnt lgkmcnt(0)
    buffer_load_dwordx4 v4, s[28:31], s21 offen offset:0 nt lds
    buffer_load_dwordx4 v5, s[28:31], s21 offen offset:1024 nt lds
    buffer_load_dwordx4 v6, s[28:31], s21 offen offset:2048 nt lds
    buffer_load_dwordx4 v7, s[28:31], s21 offen offset:3072 nt lds
    s_load_dword s53, s[44:45], s54
    s_cbranch_scc1 L_noom
    s_mov_b32 m0, 139264
    s_nop 0
    buffer_load_dwordx4 v4, s[40:43], 0 offen offset:0  lds
    buffer_load_dwordx4 v5, s[40:43], 0 offen offset:1024  lds
    buffer_load_dwordx4 v6, s[40:43], 0 offen offset:2048  lds
    buffer_load_dwordx4 v7, s[40:43], 0 offen offset:3072  lds
    v_mov_b32 v64, 147968
    v_mov_b32 v65, 0
    ds_write_b32 v64, v65
    s_waitcnt vmcnt(0) lgkmcnt(0)
L_noom:
    s_add_u32 m0, s20, 65536
    s_cmp_ge_u32 s19, 7
    s_cbranch_scc1 L_lowp
    s_setprio 1
L_lowp:
    s_barrier
    buffer_load_dwordx4 v4, s[32:35], s21 offen offset:0 nt lds
    buffer_load_dwordx4 v5, s[32:35], s21 offen offset:1024 nt lds
    buffer_load_dwordx4 v6, s[32:35], s21 offen offset:2048 nt lds
    buffer_load_dwordx4 v7, s[32:35], s21 offen offset:3072 nt lds
    s_setprio 0
    v_lshl_add_u32 v8, v2, 8, v60
    v_add_u32 v64, 139264, v8
    v_xor_b32 v65, 64, v64
    v_xor_b32 v66, 128, v64
    v_xor_b32 v67, 192, v64
    ds_read_b128 v[32:35], v64
    ds_read_b128 v[36:39], v65
    ds_read_b128 v[40:43], v66
    ds_read_b128 v[44:47], v67
    v_add_u32 v8, s20, v8
    v_xor_b32 v9, 64, v8
    v_xor_b32 v10, 128, v8
    v_xor_b32 v11, 192, v8
    s_mov_b32 s48, 0x3e9837f0
    s_mov_b32 s49, s48
    s_mov_b32 s50, 0xffff0000
    s_mov_b32 s51, 0x3fb8aa3b
    s_mov_b32 s52, 0x358637bd
    s_mov_b32 s56, 0x100001
    s_mov_b32 s57, 0x10000100
    s_mov_b32 s58, 0x200002
    s_mov_b32 s59, 0x20000200
    s_mov_b32 s60, 0x400004
    s_mov_b32 s61, 0x40000400
    s_mov_b32 s62, 0x800008
    s_mov_b32 s63, 0x80000800
    v_mov_b32 v13, 1.0
    v_lshlrev_b32 v70, 4, v1
    s_waitcnt vmcnt(4)
    ds_read_b128 v[16:19], v8
    ds_read_b128 v[20:23], v9
    ds_read_b128 v[24:27], v10
    ds_read_b128 v[28:31], v11
    s_waitcnt lgkmcnt(0)
    s_call_b64 s[68:69], L_phi
    v_and_b32 v60, 1, v2
    v_lshlrev_b32 v60, 8, v60
    v_lshrrev_b32 v61, 1, v2
    v_lshl_add_u32 v60, v61, 5, v60
    v_lshl_add_u32 v60, v3, 3, v60
    s_lshr_b32 s22, s20, 3
    s_add_u32 s22, s22, 131072
    v_add_u32 v60, s22, v60
    ds_write_b64 v60, v[68:69]
    s_mov_b32 m0, s20
    s_cmp_lt_u32 s19, 7
    s_cbranch_scc1 L_Lpath
    v_bfe_u32 v62, v1, 2, 2
    v_and_b32 v63, 3, v1
    v_and_b32 v64, 1, v3
    v_lshl_add_u32 v64, v64, 2, v62
    v_lshrrev_b32 v65, 1, v3
    v_lshl_add_u32 v66, v65, 4, v64
    v_lshlrev_b32 v66, 5, v66
    v_lshl_add_u32 v66, v63, 3, v66
    v_add_u32 v12, 131072, v66
    v_lshlrev_b32 v64, 1, v64
    v_lshl_add_u32 v66, v65, 4, v64
    v_lshlrev_b32 v66, 8, v66
    v_lshrrev_b32 v67, 1, v63
    s_and_b32 s3, s19, 7
    s_lshl_b32 s22, s3, 1
    v_or_b32 v67, s22, v67
    v_xor_b32 v67, v67, v64
    v_lshl_add_u32 v66, v67, 4, v66
    v_and_b32 v63, 1, v63
    v_lshl_add_u32 v66, v63, 3, v66
    v_add_u32 v14, 65536, v66
    v_xor_b32 v15, 16, v14
    v_add_u32 v15, 256, v15
    v_bfe_u32 v64, v2, 1, 2
    v_lshlrev_b32 v64, 10, v64
    v_lshl_add_u32 v64, v3, 8, v64
    v_lshrrev_b32 v65, 3, v2
    v_lshl_add_u32 v64, v65, 4, v64
    v_and_b32 v65, 1, v2
    v_lshl_add_u32 v64, v65, 3, v64
    s_lshl_b32 s22, s3, 5
    s_add_u32 s22, s22, 143360
    v_add_u32 v71, s22, v64
    s_lshl_b32 s22, s3, 10
    v_add_u32 v70, s22, v70
    s_add_u32 s53, s53, 0x1111
    s_bfe_u32 s64, s53, 0x40000
    s_bfe_u32 s65, s53, 0x40004
    s_bfe_u32 s66, s53, 0x40008
    s_bfe_u32 s67, s53, 0x4000c
    s_waitcnt lgkmcnt(0)
    s_barrier
    ds_read_b64_tr_b16 v[72:73], v12 offset:0
    ds_read_b64_tr_b16 v[74:75], v12 offset:256
    ds_read_b64_tr_b16 v[76:77], v12 offset:1024
    ds_read_b64_tr_b16 v[78:79], v12 offset:1280
    ds_read_b64_tr_b16 v[80:81], v12 offset:2048
    ds_read_b64_tr_b16 v[82:83], v12 offset:2304
    ds_read_b64_tr_b16 v[84:85], v12 offset:3072
    ds_read_b64_tr_b16 v[86:87], v12 offset:3328
    ds_read_b64_tr_b16 v[88:89], v12 offset:4096
    ds_read_b64_tr_b16 v[90:91], v12 offset:4352
    ds_read_b64_tr_b16 v[92:93], v12 offset:5120
    ds_read_b64_tr_b16 v[94:95], v12 offset:5376
    ds_read_b64_tr_b16 v[96:97], v12 offset:6144
    ds_read_b64_tr_b16 v[98:99], v12 offset:6400
    ds_read_b64_tr_b16 v[100:101], v12 offset:7168
    ds_read_b64_tr_b16 v[102:103], v12 offset:7424
    s_setprio 2
    s_mov_b32 s23, 0
    s_cmp_eq_u32 s19, 7
    s_cbranch_scc1 L_zw
    s_waitcnt vmcnt(0)
    buffer_load_dwordx4 v4, s[24:27], s21 offen offset:0 nt lds
    buffer_load_dwordx4 v5, s[24:27], s21 offen offset:1024 nt lds
    buffer_load_dwordx4 v6, s[24:27], s21 offen offset:2048 nt lds
    buffer_load_dwordx4 v7, s[24:27], s21 offen offset:3072 nt lds
    s_mov_b32 s16, 1
    s_barrier
    ds_read_b64_tr_b16 v[104:105], v14 offset:0
    ds_read_b64_tr_b16 v[106:107], v15 offset:0
    ds_read_b64_tr_b16 v[108:109], v14 offset:8192
    ds_read_b64_tr_b16 v[110:111], v15 offset:8192
    ds_read_b64_tr_b16 v[112:113], v14 offset:16384
    ds_read_b64_tr_b16 v[114:115], v15 offset:16384
    ds_read_b64_tr_b16 v[116:117], v14 offset:24576
    ds_read_b64_tr_b16 v[118:119], v15 offset:24576
    ds_read_b64_tr_b16 v[16:17], v14 offset:32768
    ds_read_b64_tr_b16 v[18:19], v15 offset:32768
    ds_read_b64_tr_b16 v[20:21], v14 offset:40960
    ds_read_b64_tr_b16 v[22:23], v15 offset:40960
    ds_read_b64_tr_b16 v[24:25], v14 offset:49152
    ds_read_b64_tr_b16 v[26:27], v15 offset:49152
    ds_read_b64_tr_b16 v[28:29], v14 offset:57344
    ds_read_b64_tr_b16 v[30:31], v15 offset:57344
    s_waitcnt lgkmcnt(14)
    v_mfma_f32_16x16x32_bf16 v[120:123], v[72:75], v[104:107], 0
    s_waitcnt lgkmcnt(12)
    v_mfma_f32_16x16x32_bf16 v[120:123], v[76:79], v[108:111], v[120:123]
    s_waitcnt lgkmcnt(10)
    v_mfma_f32_16x16x32_bf16 v[120:123], v[80:83], v[112:115], v[120:123]
    s_waitcnt lgkmcnt(8)
    v_mfma_f32_16x16x32_bf16 v[120:123], v[84:87], v[116:119], v[120:123]
    s_waitcnt lgkmcnt(6)
    v_mfma_f32_16x16x32_bf16 v[120:123], v[88:91], v[16:19], v[120:123]
    s_waitcnt lgkmcnt(4)
    v_mfma_f32_16x16x32_bf16 v[120:123], v[92:95], v[20:23], v[120:123]
    s_waitcnt lgkmcnt(2)
    v_mfma_f32_16x16x32_bf16 v[120:123], v[96:99], v[24:27], v[120:123]
    s_waitcnt lgkmcnt(0)
    v_mfma_f32_16x16x32_bf16 v[120:123], v[100:103], v[28:31], v[120:123]
    s_nop 7
    v_bfi_b32 v120, 15, s64, v120
    v_bfi_b32 v121, 15, s65, v121
    v_bfi_b32 v122, 15, s66, v122
    v_bfi_b32 v123, 15, s67, v123
    buffer_store_dwordx4 v[120:123], v70, s[44:47], s55 offen sc1
    s_barrier
    v_and_b32 v72, -16, v120
    v_and_b32 v73, -16, v121
    v_and_b32 v74, -16, v122
    v_and_b32 v75, -16, v123
    s_waitcnt vmcnt(1)
    ds_read_b128 v[16:19], v8
    ds_read_b128 v[20:23], v9
    ds_read_b128 v[24:27], v10
    ds_read_b128 v[28:31], v11
    s_call_b64 s[68:69], L_phi
    s_barrier
    s_xor_b32 s22, s55, 16384
    buffer_load_dwordx4 v[76:79], v70, s[44:47], s22 offen sc1
    s_xor_b32 s22, s55, 32768
    buffer_load_dwordx4 v[80:83], v70, s[44:47], s22 offen sc1
    s_xor_b32 s22, s55, 49152
    buffer_load_dwordx4 v[84:87], v70, s[44:47], s22 offen sc1
    s_xor_b32 s22, s55, 65536
    buffer_load_dwordx4 v[88:91], v70, s[44:47], s22 offen sc1
    s_xor_b32 s22, s55, 81920
    buffer_load_dwordx4 v[92:95], v70, s[44:47], s22 offen sc1
    s_xor_b32 s22, s55, 98304
    buffer_load_dwordx4 v[96:99], v70, s[44:47], s22 offen sc1
    s_xor_b32 s22, s55, 114688
    buffer_load_dwordx4 v[100:103], v70, s[44:47], s22 offen sc1
    s_branch L_check
L_phi:
    s_waitcnt lgkmcnt(3)
    v_lshlrev_b32 v60, 16, v16
    v_and_b32 v61, s50, v16
    v_lshlrev_b32 v62, 16, v17
    v_and_b32 v63, s50, v17
    v_lshlrev_b32 v64, 16, v18
    v_and_b32 v65, s50, v18
    v_lshlrev_b32 v66, 16, v19
    v_and_b32 v67, s50, v19
    v_pk_mul_f32 v[60:61], v[60:61], s[48:49]
    v_pk_mul_f32 v[62:63], v[62:63], s[48:49]
    v_pk_mul_f32 v[64:65], v[64:65], s[48:49]
    v_pk_mul_f32 v[66:67], v[66:67], s[48:49]
    v_cvt_pk_bf16_f32 v16, v60, v61
    v_cvt_pk_bf16_f32 v17, v62, v63
    v_cvt_pk_bf16_f32 v18, v64, v65
    v_cvt_pk_bf16_f32 v19, v66, v67
    s_waitcnt lgkmcnt(2)
    v_lshlrev_b32 v60, 16, v20
    v_and_b32 v61, s50, v20
    v_lshlrev_b32 v62, 16, v21
    v_and_b32 v63, s50, v21
    v_lshlrev_b32 v64, 16, v22
    v_and_b32 v65, s50, v22
    v_lshlrev_b32 v66, 16, v23
    v_and_b32 v67, s50, v23
    v_pk_mul_f32 v[60:61], v[60:61], s[48:49]
    v_pk_mul_f32 v[62:63], v[62:63], s[48:49]
    v_pk_mul_f32 v[64:65], v[64:65], s[48:49]
    v_pk_mul_f32 v[66:67], v[66:67], s[48:49]
    v_cvt_pk_bf16_f32 v20, v60, v61
    v_cvt_pk_bf16_f32 v21, v62, v63
    v_cvt_pk_bf16_f32 v22, v64, v65
    v_cvt_pk_bf16_f32 v23, v66, v67
    v_mfma_f32_16x16x32_bf16 v[52:55], v[16:19], v[16:19], 0
    v_mfma_f32_16x16x32_bf16 v[48:51], v[32:35], v[16:19], 0
    s_waitcnt lgkmcnt(1)
    v_lshlrev_b32 v60, 16, v24
    v_and_b32 v61, s50, v24
    v_lshlrev_b32 v62, 16, v25
    v_and_b32 v63, s50, v25
    v_lshlrev_b32 v64, 16, v26
    v_and_b32 v65, s50, v26
    v_lshlrev_b32 v66, 16, v27
    v_and_b32 v67, s50, v27
    v_pk_mul_f32 v[60:61], v[60:61], s[48:49]
    v_pk_mul_f32 v[62:63], v[62:63], s[48:49]
    v_pk_mul_f32 v[64:65], v[64:65], s[48:49]
    v_pk_mul_f32 v[66:67], v[66:67], s[48:49]
    v_cvt_pk_bf16_f32 v24, v60, v61
    v_cvt_pk_bf16_f32 v25, v62, v63
    v_cvt_pk_bf16_f32 v26, v64, v65
    v_cvt_pk_bf16_f32 v27, v66, v67
    v_mfma_f32_16x16x32_bf16 v[52:55], v[20:23], v[20:23], v[52:55]
    v_mfma_f32_16x16x32_bf16 v[48:51], v[36:39], v[20:23], v[48:51]
    s_waitcnt lgkmcnt(0)
    v_lshlrev_b32 v60, 16, v28
    v_and_b32 v61, s50, v28
    v_lshlrev_b32 v62, 16, v29
    v_and_b32 v63, s50, v29
    v_lshlrev_b32 v64, 16, v30
    v_and_b32 v65, s50, v30
    v_lshlrev_b32 v66, 16, v31
    v_and_b32 v67, s50, v31
    v_pk_mul_f32 v[60:61], v[60:61], s[48:49]
    v_pk_mul_f32 v[62:63], v[62:63], s[48:49]
    v_pk_mul_f32 v[64:65], v[64:65], s[48:49]
    v_pk_mul_f32 v[66:67], v[66:67], s[48:49]
    v_cvt_pk_bf16_f32 v28, v60, v61
    v_cvt_pk_bf16_f32 v29, v62, v63
    v_cvt_pk_bf16_f32 v30, v64, v65
    v_cvt_pk_bf16_f32 v31, v66, v67
    v_mfma_f32_16x16x32_bf16 v[52:55], v[24:27], v[24:27], v[52:55]
    v_mfma_f32_16x16x32_bf16 v[48:51], v[40:43], v[24:27], v[48:51]
    v_mfma_f32_16x16x32_bf16 v[52:55], v[28:31], v[28:31], v[52:55]
    v_mfma_f32_16x16x32_bf16 v[48:51], v[44:47], v[28:31], v[48:51]
    s_nop 6
    v_cndmask_b32 v60, 0, v52, s[56:57]
    v_cndmask_b32 v60, v60, v53, s[58:59]
    v_cndmask_b32 v60, v60, v54, s[60:61]
    v_cndmask_b32 v60, v60, v55, s[62:63]
    v_cvt_pk_bf16_f32 v64, v48, v49
    v_cvt_pk_bf16_f32 v65, v50, v51
    v_mfma_f32_16x16x4_f32 v[56:59], v13, v60, 0
    v_lshlrev_b32 v48, 16, v64
    v_and_b32 v49, s50, v64
    v_lshlrev_b32 v50, 16, v65
    v_and_b32 v51, s50, v65
    v_mov_b32 v66, 0x3e800000
    s_nop 4
    v_cvt_pk_bf16_f32 v60, v56, v56
    v_and_b32 v60, s50, v60
    v_fma_f32 v48, v60, -0.5, v48
    v_fma_f32 v49, v60, -0.5, v49
    v_fma_f32 v50, v60, -0.5, v50
    v_fma_f32 v51, v60, -0.5, v51
    v_cvt_pk_bf16_f32 v64, v48, v49
    v_cvt_pk_bf16_f32 v65, v50, v51
    v_lshlrev_b32 v48, 16, v64
    v_and_b32 v49, s50, v64
    v_lshlrev_b32 v50, 16, v65
    v_and_b32 v51, s50, v65
    v_mul_f32 v48, s51, v48
    v_mul_f32 v49, s51, v49
    v_mul_f32 v50, s51, v50
    v_mul_f32 v51, s51, v51
    v_exp_f32 v48, v48
    v_exp_f32 v49, v49
    v_exp_f32 v50, v50
    v_exp_f32 v51, v51
    s_nop 0
    v_cvt_pk_bf16_f32 v64, v48, v49
    v_cvt_pk_bf16_f32 v65, v50, v51
    v_lshlrev_b32 v48, 16, v64
    v_and_b32 v49, s50, v64
    v_lshlrev_b32 v50, 16, v65
    v_and_b32 v51, s50, v65
    v_fma_f32 v48, v48, v66, s52
    v_fma_f32 v49, v49, v66, s52
    v_fma_f32 v50, v50, v66, s52
    v_fma_f32 v51, v51, v66, s52
    v_cvt_pk_bf16_f32 v68, v48, v49
    v_cvt_pk_bf16_f32 v69, v50, v51
    s_setpc_b64 s[68:69]
L_den:
    v_mov_b32 v64, 147968
    v_lshlrev_b32 v61, 3, v1
    v_add_u32 v61, 147456, v61
L_zspin:
    ds_read_b32 v65, v64
    ds_read_b64 v[120:121], v61
    s_waitcnt lgkmcnt(0)
    v_cmp_gt_u32 vcc, 0x100, v65
    s_cbranch_vccz L_zgo
    s_sleep 1
    s_branch L_zspin
L_zgo:
    v_mfma_f32_16x16x16_bf16 v[124:127], v[68:69], v[120:121], 0
    v_lshlrev_b32 v4, 4, v1
    v_add_u32 v4, 143360, v4
    v_lshlrev_b32 v12, 4, v2
    v_lshl_add_u32 v12, v3, 10, v12
    v_mov_b32 v5, 147968
    s_nop 2
    v_cvt_pk_bf16_f32 v64, v124, v125
    v_cvt_pk_bf16_f32 v65, v126, v127
    v_lshlrev_b32 v124, 16, v64
    v_and_b32 v125, s50, v64
    v_lshlrev_b32 v126, 16, v65
    v_and_b32 v127, s50, v65
    v_add_f32 v124, s52, v124
    v_add_f32 v125, s52, v125
    v_add_f32 v126, s52, v126
    v_add_f32 v127, s52, v127
    v_cvt_pk_bf16_f32 v64, v124, v125
    v_cvt_pk_bf16_f32 v65, v126, v127
    v_lshlrev_b32 v124, 16, v64
    v_and_b32 v125, s50, v64
    v_lshlrev_b32 v126, 16, v65
    v_and_b32 v127, s50, v65
    v_rcp_f32 v124, v124
    v_rcp_f32 v125, v125
    v_rcp_f32 v126, v126
    v_rcp_f32 v127, v127
    s_setpc_b64 s[68:69]
L_Lpath:
    s_waitcnt lgkmcnt(0)
    s_barrier
    s_waitcnt vmcnt(0)
    s_barrier
    s_barrier
    buffer_load_dwordx4 v4, s[24:27], s21 offen offset:0 nt lds
    buffer_load_dwordx4 v5, s[24:27], s21 offen offset:1024 nt lds
    buffer_load_dwordx4 v6, s[24:27], s21 offen offset:2048 nt lds
    buffer_load_dwordx4 v7, s[24:27], s21 offen offset:3072 nt lds
    s_barrier
    s_waitcnt vmcnt(0)
    ds_read_b128 v[16:19], v8
    ds_read_b128 v[20:23], v9
    ds_read_b128 v[24:27], v10
    ds_read_b128 v[28:31], v11
    s_call_b64 s[68:69], L_phi
    s_branch L_lastden
L_zw:
    v_mov_b32 v60, 0x3f803f80
    v_mov_b32 v61, v60
    v_mov_b32 v62, v60
    v_mov_b32 v63, v60
    v_lshlrev_b32 v70, 4, v3
    v_add_u32 v70, 8192, v70
    v_lshlrev_b32 v71, 3, v1
    v_add_u32 v71, 147456, v71
    s_mov_b32 s16, 0x100
    s_waitcnt lgkmcnt(0)
    v_mfma_f32_16x16x32_bf16 v[120:123], v[72:75], v[60:63], 0
    v_mfma_f32_16x16x32_bf16 v[120:123], v[76:79], v[60:63], v[120:123]
    v_mfma_f32_16x16x32_bf16 v[120:123], v[80:83], v[60:63], v[120:123]
    v_mfma_f32_16x16x32_bf16 v[120:123], v[84:87], v[60:63], v[120:123]
    v_mfma_f32_16x16x32_bf16 v[120:123], v[88:91], v[60:63], v[120:123]
    v_mfma_f32_16x16x32_bf16 v[120:123], v[92:95], v[60:63], v[120:123]
    v_mfma_f32_16x16x32_bf16 v[120:123], v[96:99], v[60:63], v[120:123]
    v_mfma_f32_16x16x32_bf16 v[120:123], v[100:103], v[60:63], v[120:123]
    s_nop 7
    v_bfi_b32 v120, 15, s64, v120
    v_bfi_b32 v121, 15, s65, v121
    v_bfi_b32 v122, 15, s66, v122
    v_bfi_b32 v123, 15, s67, v123
    s_mov_b32 exec_lo, 0x00010001
    s_mov_b32 exec_hi, 0x00010001
    buffer_store_dwordx4 v[120:123], v70, s[44:47], s55 offen sc1
    s_mov_b64 exec, -1
    s_waitcnt vmcnt(1)
    buffer_load_dwordx4 v4, s[24:27], s21 offen offset:0 nt lds
    buffer_load_dwordx4 v5, s[24:27], s21 offen offset:1024 nt lds
    buffer_load_dwordx4 v6, s[24:27], s21 offen offset:2048 nt lds
    buffer_load_dwordx4 v7, s[24:27], s21 offen offset:3072 nt lds
    v_and_b32 v72, -16, v120
    v_and_b32 v73, -16, v121
    v_and_b32 v74, -16, v122
    v_and_b32 v75, -16, v123
    s_barrier
    s_barrier
    s_xor_b32 s22, s55, 16384
    buffer_load_dwordx4 v[76:79], v70, s[44:47], s22 offen sc1
    s_xor_b32 s22, s55, 32768
    buffer_load_dwordx4 v[80:83], v70, s[44:47], s22 offen sc1
    s_xor_b32 s22, s55, 49152
    buffer_load_dwordx4 v[84:87], v70, s[44:47], s22 offen sc1
    s_xor_b32 s22, s55, 65536
    buffer_load_dwordx4 v[88:91], v70, s[44:47], s22 offen sc1
    s_xor_b32 s22, s55, 81920
    buffer_load_dwordx4 v[92:95], v70, s[44:47], s22 offen sc1
    s_xor_b32 s22, s55, 98304
    buffer_load_dwordx4 v[96:99], v70, s[44:47], s22 offen sc1
    s_xor_b32 s22, s55, 114688
    buffer_load_dwordx4 v[100:103], v70, s[44:47], s22 offen sc1
    s_waitcnt vmcnt(7)
    ds_read_b128 v[16:19], v8
    ds_read_b128 v[20:23], v9
    ds_read_b128 v[24:27], v10
    ds_read_b128 v[28:31], v11
    s_call_b64 s[68:69], L_phi
    s_barrier
    s_branch L_check
L_retry:
    v_or_b32 v60, v76, v77
    v_or3_b32 v60, v78, v79, v60
    v_and_b32 v60, 15, v60
    v_cmp_ne_u32 vcc, 0, v60
    s_cbranch_vccz L_rt1
    s_xor_b32 s22, s55, 16384
    buffer_load_dwordx4 v[76:79], v70, s[44:47], s22 offen sc1
    s_branch L_ru1
L_rt1:
    v_xor_b32 v76, s64, v76
    v_xor_b32 v77, s65, v77
    v_xor_b32 v78, s66, v78
    v_xor_b32 v79, s67, v79
L_ru1:
    v_or_b32 v60, v80, v81
    v_or3_b32 v60, v82, v83, v60
    v_and_b32 v60, 15, v60
    v_cmp_ne_u32 vcc, 0, v60
    s_cbranch_vccz L_rt2
    s_xor_b32 s22, s55, 32768
    buffer_load_dwordx4 v[80:83], v70, s[44:47], s22 offen sc1
    s_branch L_ru2
L_rt2:
    v_xor_b32 v80, s64, v80
    v_xor_b32 v81, s65, v81
    v_xor_b32 v82, s66, v82
    v_xor_b32 v83, s67, v83
L_ru2:
    v_or_b32 v60, v84, v85
    v_or3_b32 v60, v86, v87, v60
    v_and_b32 v60, 15, v60
    v_cmp_ne_u32 vcc, 0, v60
    s_cbranch_vccz L_rt3
    s_xor_b32 s22, s55, 49152
    buffer_load_dwordx4 v[84:87], v70, s[44:47], s22 offen sc1
    s_branch L_ru3
L_rt3:
    v_xor_b32 v84, s64, v84
    v_xor_b32 v85, s65, v85
    v_xor_b32 v86, s66, v86
    v_xor_b32 v87, s67, v87
L_ru3:
    v_or_b32 v60, v88, v89
    v_or3_b32 v60, v90, v91, v60
    v_and_b32 v60, 15, v60
    v_cmp_ne_u32 vcc, 0, v60
    s_cbranch_vccz L_rt4
    s_xor_b32 s22, s55, 65536
    buffer_load_dwordx4 v[88:91], v70, s[44:47], s22 offen sc1
    s_branch L_ru4
L_rt4:
    v_xor_b32 v88, s64, v88
    v_xor_b32 v89, s65, v89
    v_xor_b32 v90, s66, v90
    v_xor_b32 v91, s67, v91
L_ru4:
    v_or_b32 v60, v92, v93
    v_or3_b32 v60, v94, v95, v60
    v_and_b32 v60, 15, v60
    v_cmp_ne_u32 vcc, 0, v60
    s_cbranch_vccz L_rt5
    s_xor_b32 s22, s55, 81920
    buffer_load_dwordx4 v[92:95], v70, s[44:47], s22 offen sc1
    s_branch L_ru5
L_rt5:
    v_xor_b32 v92, s64, v92
    v_xor_b32 v93, s65, v93
    v_xor_b32 v94, s66, v94
    v_xor_b32 v95, s67, v95
L_ru5:
    v_or_b32 v60, v96, v97
    v_or3_b32 v60, v98, v99, v60
    v_and_b32 v60, 15, v60
    v_cmp_ne_u32 vcc, 0, v60
    s_cbranch_vccz L_rt6
    s_xor_b32 s22, s55, 98304
    buffer_load_dwordx4 v[96:99], v70, s[44:47], s22 offen sc1
    s_branch L_ru6
L_rt6:
    v_xor_b32 v96, s64, v96
    v_xor_b32 v97, s65, v97
    v_xor_b32 v98, s66, v98
    v_xor_b32 v99, s67, v99
L_ru6:
    v_or_b32 v60, v100, v101
    v_or3_b32 v60, v102, v103, v60
    v_and_b32 v60, 15, v60
    v_cmp_ne_u32 vcc, 0, v60
    s_cbranch_vccz L_rt7
    s_xor_b32 s22, s55, 114688
    buffer_load_dwordx4 v[100:103], v70, s[44:47], s22 offen sc1
    s_branch L_ru7
L_rt7:
    v_xor_b32 v100, s64, v100
    v_xor_b32 v101, s65, v101
    v_xor_b32 v102, s66, v102
    v_xor_b32 v103, s67, v103
L_ru7:
    s_waitcnt vmcnt(0)
L_check:
    s_waitcnt vmcnt(6)
    v_xor_b32 v76, s64, v76
    v_xor_b32 v77, s65, v77
    v_xor_b32 v78, s66, v78
    v_xor_b32 v79, s67, v79
    v_or_b32 v60, v76, v77
    v_or3_b32 v60, v78, v79, v60
    v_pk_add_f32 v[104:105], v[72:73], v[76:77]
    v_pk_add_f32 v[106:107], v[74:75], v[78:79]
    s_waitcnt vmcnt(5)
    v_xor_b32 v80, s64, v80
    v_xor_b32 v81, s65, v81
    v_xor_b32 v82, s66, v82
    v_xor_b32 v83, s67, v83
    v_or3_b32 v60, v80, v81, v60
    v_or3_b32 v60, v82, v83, v60
    s_waitcnt vmcnt(4)
    v_xor_b32 v84, s64, v84
    v_xor_b32 v85, s65, v85
    v_xor_b32 v86, s66, v86
    v_xor_b32 v87, s67, v87
    v_or3_b32 v60, v84, v85, v60
    v_or3_b32 v60, v86, v87, v60
    v_pk_add_f32 v[108:109], v[80:81], v[84:85]
    v_pk_add_f32 v[110:111], v[82:83], v[86:87]
    v_pk_add_f32 v[104:105], v[104:105], v[108:109]
    v_pk_add_f32 v[106:107], v[106:107], v[110:111]
    s_waitcnt vmcnt(3)
    v_xor_b32 v88, s64, v88
    v_xor_b32 v89, s65, v89
    v_xor_b32 v90, s66, v90
    v_xor_b32 v91, s67, v91
    v_or3_b32 v60, v88, v89, v60
    v_or3_b32 v60, v90, v91, v60
    s_waitcnt vmcnt(2)
    v_xor_b32 v92, s64, v92
    v_xor_b32 v93, s65, v93
    v_xor_b32 v94, s66, v94
    v_xor_b32 v95, s67, v95
    v_or3_b32 v60, v92, v93, v60
    v_or3_b32 v60, v94, v95, v60
    v_pk_add_f32 v[112:113], v[88:89], v[92:93]
    v_pk_add_f32 v[114:115], v[90:91], v[94:95]
    s_waitcnt vmcnt(1)
    v_xor_b32 v96, s64, v96
    v_xor_b32 v97, s65, v97
    v_xor_b32 v98, s66, v98
    v_xor_b32 v99, s67, v99
    v_or3_b32 v60, v96, v97, v60
    v_or3_b32 v60, v98, v99, v60
    s_waitcnt vmcnt(0)
    v_xor_b32 v100, s64, v100
    v_xor_b32 v101, s65, v101
    v_xor_b32 v102, s66, v102
    v_xor_b32 v103, s67, v103
    v_or3_b32 v60, v100, v101, v60
    v_or3_b32 v60, v102, v103, v60
    v_pk_add_f32 v[116:117], v[96:97], v[100:101]
    v_pk_add_f32 v[118:119], v[98:99], v[102:103]
    v_pk_add_f32 v[112:113], v[112:113], v[116:117]
    v_pk_add_f32 v[114:115], v[114:115], v[118:119]
    v_and_b32 v60, 15, v60
    v_cmp_ne_u32 vcc, 0, v60
    v_pk_add_f32 v[104:105], v[104:105], v[112:113]
    v_pk_add_f32 v[106:107], v[106:107], v[114:115]
    s_cbranch_vccz L_pdone
    s_add_u32 s23, s23, 1
    s_cmp_le_u32 s23, 0x40000
    s_cbranch_scc1 L_retry
L_pdone:
    v_cvt_pk_bf16_f32 v62, v104, v105
    v_cvt_pk_bf16_f32 v63, v106, v107
    v_mov_b32 v64, 147968
    v_mov_b32 v65, s16
    ds_write_b64 v71, v[62:63]
    s_mov_b64 exec, 1
    ds_add_u32 v64, v65
    s_mov_b64 exec, -1
    s_setprio 0
    s_cmp_lg_u32 s19, 7
    s_cbranch_scc1 L_lastden
    s_and_b32 s22, s18, 7
    s_cbranch_scc1 L_lastden
    v_mov_b32 v64, s54
    v_mov_b32 v65, s53
    buffer_store_dword v65, v64, s[44:47], 0 offen
L_lastden:
    s_call_b64 s[68:69], L_den
L_spin:
    ds_read_b32 v65, v5
    ds_read_b128 v[104:107], v4 offset:0
    ds_read_b128 v[108:111], v4 offset:1024
    ds_read_b128 v[112:115], v4 offset:2048
    ds_read_b128 v[116:119], v4 offset:3072
    s_waitcnt lgkmcnt(4)
    v_cmp_ne_u32 vcc, 0x108, v65
    s_cbranch_vccz L_go
    s_sleep 1
    s_branch L_spin
L_go:
    s_waitcnt lgkmcnt(3)
    v_mfma_f32_16x16x16_bf16 v[72:75], v[68:69], v[104:105], 0
    v_mfma_f32_16x16x16_bf16 v[76:79], v[68:69], v[106:107], 0
    s_waitcnt lgkmcnt(2)
    v_mfma_f32_16x16x16_bf16 v[80:83], v[68:69], v[108:109], 0
    v_mfma_f32_16x16x16_bf16 v[84:87], v[68:69], v[110:111], 0
    s_waitcnt lgkmcnt(1)
    v_mfma_f32_16x16x16_bf16 v[88:91], v[68:69], v[112:113], 0
    v_mfma_f32_16x16x16_bf16 v[92:95], v[68:69], v[114:115], 0
    s_waitcnt lgkmcnt(0)
    v_mfma_f32_16x16x16_bf16 v[96:99], v[68:69], v[116:117], 0
    v_mfma_f32_16x16x16_bf16 v[100:103], v[68:69], v[118:119], 0
    s_nop 4
    v_cvt_pk_bf16_f32 v16, v72, v76
    v_cvt_pk_bf16_f32 v17, v80, v84
    v_cvt_pk_bf16_f32 v18, v88, v92
    v_cvt_pk_bf16_f32 v19, v96, v100
    v_lshlrev_b32 v60, 16, v16
    v_and_b32 v61, s50, v16
    v_lshlrev_b32 v62, 16, v17
    v_and_b32 v63, s50, v17
    v_lshlrev_b32 v64, 16, v18
    v_and_b32 v65, s50, v18
    v_lshlrev_b32 v66, 16, v19
    v_and_b32 v67, s50, v19
    v_pk_mul_f32 v[60:61], v[60:61], v[124:125] op_sel:[0,0] op_sel_hi:[1,0]
    v_pk_mul_f32 v[62:63], v[62:63], v[124:125] op_sel:[0,0] op_sel_hi:[1,0]
    v_pk_mul_f32 v[64:65], v[64:65], v[124:125] op_sel:[0,0] op_sel_hi:[1,0]
    v_pk_mul_f32 v[66:67], v[66:67], v[124:125] op_sel:[0,0] op_sel_hi:[1,0]
    v_cvt_pk_bf16_f32 v16, v60, v61
    v_cvt_pk_bf16_f32 v17, v62, v63
    v_cvt_pk_bf16_f32 v18, v64, v65
    v_cvt_pk_bf16_f32 v19, v66, v67
    buffer_store_dwordx4 v[16:19], v12, s[36:39], s21 offen offset:0 nt
    v_cvt_pk_bf16_f32 v20, v73, v77
    v_cvt_pk_bf16_f32 v21, v81, v85
    v_cvt_pk_bf16_f32 v22, v89, v93
    v_cvt_pk_bf16_f32 v23, v97, v101
    v_lshlrev_b32 v60, 16, v20
    v_and_b32 v61, s50, v20
    v_lshlrev_b32 v62, 16, v21
    v_and_b32 v63, s50, v21
    v_lshlrev_b32 v64, 16, v22
    v_and_b32 v65, s50, v22
    v_lshlrev_b32 v66, 16, v23
    v_and_b32 v67, s50, v23
    v_pk_mul_f32 v[60:61], v[60:61], v[124:125] op_sel:[0,1] op_sel_hi:[1,1]
    v_pk_mul_f32 v[62:63], v[62:63], v[124:125] op_sel:[0,1] op_sel_hi:[1,1]
    v_pk_mul_f32 v[64:65], v[64:65], v[124:125] op_sel:[0,1] op_sel_hi:[1,1]
    v_pk_mul_f32 v[66:67], v[66:67], v[124:125] op_sel:[0,1] op_sel_hi:[1,1]
    v_cvt_pk_bf16_f32 v20, v60, v61
    v_cvt_pk_bf16_f32 v21, v62, v63
    v_cvt_pk_bf16_f32 v22, v64, v65
    v_cvt_pk_bf16_f32 v23, v66, v67
    buffer_store_dwordx4 v[20:23], v12, s[36:39], s21 offen offset:256 nt
    v_cvt_pk_bf16_f32 v24, v74, v78
    v_cvt_pk_bf16_f32 v25, v82, v86
    v_cvt_pk_bf16_f32 v26, v90, v94
    v_cvt_pk_bf16_f32 v27, v98, v102
    v_lshlrev_b32 v60, 16, v24
    v_and_b32 v61, s50, v24
    v_lshlrev_b32 v62, 16, v25
    v_and_b32 v63, s50, v25
    v_lshlrev_b32 v64, 16, v26
    v_and_b32 v65, s50, v26
    v_lshlrev_b32 v66, 16, v27
    v_and_b32 v67, s50, v27
    v_pk_mul_f32 v[60:61], v[60:61], v[126:127] op_sel:[0,0] op_sel_hi:[1,0]
    v_pk_mul_f32 v[62:63], v[62:63], v[126:127] op_sel:[0,0] op_sel_hi:[1,0]
    v_pk_mul_f32 v[64:65], v[64:65], v[126:127] op_sel:[0,0] op_sel_hi:[1,0]
    v_pk_mul_f32 v[66:67], v[66:67], v[126:127] op_sel:[0,0] op_sel_hi:[1,0]
    v_cvt_pk_bf16_f32 v24, v60, v61
    v_cvt_pk_bf16_f32 v25, v62, v63
    v_cvt_pk_bf16_f32 v26, v64, v65
    v_cvt_pk_bf16_f32 v27, v66, v67
    buffer_store_dwordx4 v[24:27], v12, s[36:39], s21 offen offset:512 nt
    v_cvt_pk_bf16_f32 v28, v75, v79
    v_cvt_pk_bf16_f32 v29, v83, v87
    v_cvt_pk_bf16_f32 v30, v91, v95
    v_cvt_pk_bf16_f32 v31, v99, v103
    v_lshlrev_b32 v60, 16, v28
    v_and_b32 v61, s50, v28
    v_lshlrev_b32 v62, 16, v29
    v_and_b32 v63, s50, v29
    v_lshlrev_b32 v64, 16, v30
    v_and_b32 v65, s50, v30
    v_lshlrev_b32 v66, 16, v31
    v_and_b32 v67, s50, v31
    v_pk_mul_f32 v[60:61], v[60:61], v[126:127] op_sel:[0,1] op_sel_hi:[1,1]
    v_pk_mul_f32 v[62:63], v[62:63], v[126:127] op_sel:[0,1] op_sel_hi:[1,1]
    v_pk_mul_f32 v[64:65], v[64:65], v[126:127] op_sel:[0,1] op_sel_hi:[1,1]
    v_pk_mul_f32 v[66:67], v[66:67], v[126:127] op_sel:[0,1] op_sel_hi:[1,1]
    v_cvt_pk_bf16_f32 v28, v60, v61
    v_cvt_pk_bf16_f32 v29, v62, v63
    v_cvt_pk_bf16_f32 v30, v64, v65
    v_cvt_pk_bf16_f32 v31, v66, v67
    buffer_store_dwordx4 v[28:31], v12, s[36:39], s21 offen offset:768 nt
L_end:
    s_endpgm
.section .rodata,"a"
.p2align 6
.amdhsa_kernel standalone__linear_kernel_rfa__prompt_kernel
  .amdhsa_next_free_vgpr 128
  .amdhsa_next_free_sgpr 96
  .amdhsa_accum_offset 128
  .amdhsa_group_segment_fixed_size 0
  .amdhsa_kernarg_size 56
  .amdhsa_user_sgpr_count 2
  .amdhsa_user_sgpr_kernarg_segment_ptr 1
  .amdhsa_system_sgpr_workgroup_id_x 1
  .amdhsa_float_denorm_mode_32 3
.end_amdhsa_kernel
```
